```python
import torch

def _softmax(x, axis=-1):
    return torch.softmax(x, dim=axis)
def _gelu(x):
    return torch.nn.functional.gelu(x, approximate="tanh")
def _silu(x):
    return torch.nn.functional.silu(x)
def _sigmoid(x):
    return torch.sigmoid(x)
def _layernorm(x, axis=-1, eps=1e-5):
    m = x.mean(dim=axis, keepdim=True)
    v = x.var(dim=axis, keepdim=True, unbiased=False)
    return (x - m) / torch.sqrt(v + eps)
def _scatter_add(tgt, idx, src, axis=0):
    return tgt.clone().index_add_(axis, idx, src)
def _segment_sum(src, seg, n):
    out = torch.zeros((n,) + src.shape[1:], dtype=src.dtype)
    return out.index_add_(0, seg, src)
def _pad(x, pw):
    flat = tuple(v for pair in reversed(pw) for v in pair)
    return torch.nn.functional.pad(x, flat)

kernel_name = 'recurrent_scan__sliding_block_cached__mixer_channel_mlp__decode'

def setup_inputs():

    _w = (lambda a: (lambda t: t.to(torch.bfloat16) if t.is_floating_point() else t)(torch.as_tensor(a)))
    def _A_setup():
        B, Sq, D = 1, 1, 512
        Hq, Hkv, Sk, Dh = 32, 32, 8192, 128
        assert Hq % Hkv == 0, (Hq, Hkv)
        return {
            "x": _w((lambda *s: torch.randn(*s, dtype=torch.bfloat16) * 0.05)(B, Sq, D)),
            "k_cache": _w((lambda *s: torch.randn(*s, dtype=torch.bfloat16) * 3.2)(B, Hkv, Sk, Dh)),
            "v_cache": _w((lambda *s: torch.randn(*s, dtype=torch.bfloat16) * 3.2)(B, Hkv, Sk, Dh)),
            "wq": _w((lambda *s: torch.randn(*s, dtype=torch.bfloat16) * 3.2)(D, Hq * Dh) * (D ** -0.5)),
            "wo": _w((lambda *s: torch.randn(*s, dtype=torch.bfloat16) * 3.2)(Hq * Dh, D) * ((Hq * Dh) ** -0.5)),
        }
    _A_in = _A_setup()

    def _B_setup():
        B, S, D, F = 1, 1, 512, 1376
        return {
            "x": _w((lambda *s: torch.randn(*s, dtype=torch.bfloat16) * 0.05)(B, S, D)),
            "w1": _w((lambda *s: torch.randn(*s, dtype=torch.bfloat16) * 3.2)(D, F) * (D ** -0.5)),
            "b1": _w((lambda *s: torch.randn(*s, dtype=torch.bfloat16) * 3.2)(F)),
            "w2": _w((lambda *s: torch.randn(*s, dtype=torch.bfloat16) * 0.4)(F, D) * (F ** -0.5)),
            "b2": _w((lambda *s: torch.randn(*s, dtype=torch.bfloat16) * 0.4)(D)),
        }
    _B_in = _B_setup()

    return {
        "A_x": _A_in["x"],
        "A_k_cache": _A_in["k_cache"],
        "A_v_cache": _A_in["v_cache"],
        "A_wq": _A_in["wq"],
        "A_wo": _A_in["wo"],
        "B_x": _B_in["x"],
        "B_w1": _B_in["w1"],
        "B_b1": _B_in["b1"],
        "B_w2": _B_in["w2"],
        "B_b2": _B_in["b2"],
    }

def reference(A_x, A_k_cache, A_v_cache, A_wq, A_wo, B_x, B_w1, B_b1, B_w2, B_b2):
    def _A_ref(x, k_cache, v_cache, wq, wo):
        B, Sq, D = x.shape
        Hq, Dh = 32, 128
        Hkv, Sk = k_cache.shape[1], k_cache.shape[2]
        W = min(4096, max(256, Sk // 4))
        rep = Hq // Hkv
        q = (lambda x, *d: x.permute(*d))((x @ wq).reshape(B, Sq, Hq, Dh), 0, 2, 1, 3)
        k = (lambda x, n, axis: torch.repeat_interleave(x, n, dim=axis))(k_cache[:, :, Sk - W:, :], rep, axis=1)
        v = (lambda x, n, axis: torch.repeat_interleave(x, n, dim=axis))(v_cache[:, :, Sk - W:, :], rep, axis=1)
        scores = torch.einsum("bhqd,bhkd->bhqk", q, k) * (Dh ** -0.5)
        p = _softmax(scores, axis=-1)
        o = torch.einsum("bhqk,bhkd->bhqd", p, v)
        return (lambda x, *d: x.permute(*d))(o, 0, 2, 1, 3).reshape(B, Sq, Hq * Dh) @ wo

    def _B_ref(x, w1, b1, w2, b2):
        y = _layernorm(x, axis=-1)
        h = _gelu(torch.einsum("bsd,df->bsf", y, w1) + b1)
        return torch.einsum("bsf,fd->bsd", h, w2) + b2

    x = A_x
    xn = _layernorm(x, axis=-1)
    s = _A_ref(xn, A_k_cache, A_v_cache, A_wq, A_wo)
    g = _silu(_B_ref(xn, B_w1, B_b1, B_w2, B_b2))
    return x + s * g
```

```asm
; @launch grid=(256,1,1) block=(320,1,1) lds=27072
    .amdgcn_target "amdgcn-amd-amdhsa--gfx950"
    .text
    .p2align 12
    .globl recurrent_scan__sliding_block_cached__mixer_channel_mlp__decode_kernel
    .p2align 8
    .type recurrent_scan__sliding_block_cached__mixer_channel_mlp__decode_kernel,@function
recurrent_scan__sliding_block_cached__mixer_channel_mlp__decode_kernel:
    s_load_dwordx16 s[36:51], s[0:1], 0
    s_load_dwordx8 s[52:59], s[0:1], 64
    s_load_dwordx2 s[32:33], s[0:1], 96
    s_cmp_ge_u32 s2, 256
    s_cbranch_scc1 L_end
    v_lshrrev_b32 v1, 6, v0
    v_and_b32 v0, 63, v0
    s_and_b32 s4, s2, 7
    s_lshl_b32 s4, s4, 2
    s_lshr_b32 s5, s2, 6
    s_add_u32 s4, s4, s5
    v_readfirstlane_b32 s3, v1
    s_lshr_b32 s5, s2, 3
    s_and_b32 s5, s5, 7
    s_mov_b32 s11, 0x20000
    s_mov_b32 s15, 0x20000
    s_min_u32 s6, s4, 12
    s_mul_i32 s7, s4, 5
    s_add_u32 s6, s6, s7
    v_lshrrev_b32 v6, 4, v0
    v_and_b32 v7, 15, v0
    s_cmp_lg_u32 s3, 0
    s_cbranch_scc1 L_kv
    s_setprio 3
    v_lshrrev_b32 v1, 1, v7
    v_add_u32 v1, s5, v1
    v_and_b32 v1, 7, v1
    v_lshl_add_u32 v1, v1, 2, v6
    v_and_b32 v2, 1, v0
    v_lshl_add_u32 v1, v1, 1, v2
    v_lshlrev_b32 v1, 4, v1
    v_lshlrev_b32 v2, 17, v6
    v_lshl_add_u32 v2, v7, 4, v2
    s_lshl_b32 s62, s5, 19
    s_lshl_b32 s7, s4, 8
    s_add_u32 s62, s62, s7
    s_mov_b32 s10, 4194304
    s_waitcnt lgkmcnt(0)
    global_load_dwordx4 v[8:11], v1, s[36:37]
    s_mov_b64 s[8:9], s[42:43]
    buffer_load_dwordx4 v[76:79], v2, s[8:11], s62 offen nt
    s_add_u32 s62, s62, 8192
    buffer_load_dwordx4 v[80:83], v2, s[8:11], s62 offen nt
    s_add_u32 s62, s62, 8192
    buffer_load_dwordx4 v[84:87], v2, s[8:11], s62 offen nt
    s_add_u32 s62, s62, 8192
    buffer_load_dwordx4 v[88:91], v2, s[8:11], s62 offen nt
    s_add_u32 s62, s62, 8192
    buffer_load_dwordx4 v[92:95], v2, s[8:11], s62 offen nt
    s_add_u32 s62, s62, 8192
    buffer_load_dwordx4 v[96:99], v2, s[8:11], s62 offen nt
    s_add_u32 s62, s62, 8192
    buffer_load_dwordx4 v[100:103], v2, s[8:11], s62 offen nt
    s_add_u32 s62, s62, 8192
    buffer_load_dwordx4 v[104:107], v2, s[8:11], s62 offen nt
    s_add_u32 s62, s62, 8192
    buffer_load_dwordx4 v[108:111], v2, s[8:11], s62 offen nt
    s_add_u32 s62, s62, 8192
    buffer_load_dwordx4 v[112:115], v2, s[8:11], s62 offen nt
    s_add_u32 s62, s62, 8192
    buffer_load_dwordx4 v[116:119], v2, s[8:11], s62 offen nt
    s_add_u32 s62, s62, 8192
    buffer_load_dwordx4 v[120:123], v2, s[8:11], s62 offen nt
    s_add_u32 s62, s62, 8192
    buffer_load_dwordx4 v[124:127], v2, s[8:11], s62 offen nt
    s_add_u32 s62, s62, 8192
    buffer_load_dwordx4 v[128:131], v2, s[8:11], s62 offen nt
    s_add_u32 s62, s62, 8192
    buffer_load_dwordx4 v[132:135], v2, s[8:11], s62 offen nt
    s_add_u32 s62, s62, 8192
    buffer_load_dwordx4 v[136:139], v2, s[8:11], s62 offen nt
    s_barrier
    s_branch L_q2
L_kv:
    s_sub_u32 s7, s3, 1
    s_lshl_b32 s60, s4, 21
    s_lshl_b32 s61, s5, 16
    s_add_u32 s60, s60, s61
    s_add_u32 s60, s60, 1572864
    s_mul_i32 s84, s2, 5
    s_add_u32 s84, s84, s7
    s_and_b32 s84, s84, 63
    s_lshl_b32 s84, s84, 10
    v_lshlrev_b32 v69, 4, v0
    s_mov_b32 s10, 0x10000
    s_mov_b32 s14, 0x10000
    s_lshl_b32 s61, s4, 3
    s_add_u32 s61, s61, s5
    s_lshl_b32 s61, s61, 9
    s_add_u32 s61, s61, 266240
    v_and_b32 v2, 7, v0
    v_lshl_add_u32 v2, v2, 6, s61
    s_mov_b32 s64, 1
    s_cmp_lg_u32 s7, 2
    s_cbranch_scc1 L_nw2
    s_cmp_ge_u32 s2, 64
    s_cbranch_scc1 L_nw2
    s_and_b32 s65, s2, 7
    s_lshl_b32 s65, s65, 3
    s_lshr_b32 s62, s2, 3
    s_add_u32 s65, s65, s62
    s_lshr_b32 s62, s65, 1
    s_lshl_b32 s62, s62, 13
    s_and_b32 s63, s65, 1
    s_lshl_b32 s63, s63, 7
    s_add_u32 s62, s62, s63
    s_add_u32 s62, s62, 397312
    v_lshrrev_b32 v2, 1, v0
    v_lshl_add_u32 v2, v2, 8, s62
    v_and_b32 v3, 1, v0
    v_lshl_add_u32 v2, v3, 6, v2
    s_mov_b32 s64, 2
L_nw2:
    s_or_b32 s8, s7, s5
    s_cmp_lg_u32 s8, 0
    s_cbranch_scc1 L_nopf
L_pc:
    s_getpc_b64 s[8:9]
    s_sub_u32 s8, s8, L_pc+4-recurrent_scan__sliding_block_cached__mixer_channel_mlp__decode_kernel
    s_subb_u32 s9, s9, 0
    v_lshlrev_b32 v3, 7, v0
    v_add_u32 v3, 512, v3
    v_min_u32 v3, L_end-recurrent_scan__sliding_block_cached__mixer_channel_mlp__decode_kernel, v3
    global_load_dword v75, v3, s[8:9]
    v_add_u32 v3, 0x2000, v3
    v_min_u32 v3, L_end-recurrent_scan__sliding_block_cached__mixer_channel_mlp__decode_kernel, v3
    global_load_dword v73, v3, s[8:9]
L_nopf:
    s_waitcnt lgkmcnt(0)
    s_add_u32 s8, s38, s60
    s_addc_u32 s9, s39, 0
    s_add_u32 s12, s40, s60
    s_addc_u32 s13, s41, 0
    v_mov_b32 v3, 0
    ds_write_b32 v3, v3 offset:24992
    s_waitcnt lgkmcnt(0)
    s_cmp_lg_u32 s7, s64
    s_cbranch_scc1 L_nw
    global_load_dword v74, v2, s[32:33]
L_nw:
    s_barrier
    buffer_load_dwordx4 v[76:79], v69, s[8:11], s84 offen nt
    s_add_u32 s84, s84, 4096
    s_and_b32 s84, s84, 0xffff
    buffer_load_dwordx4 v[80:83], v69, s[8:11], s84 offen nt
    s_add_u32 s84, s84, 4096
    s_and_b32 s84, s84, 0xffff
    buffer_load_dwordx4 v[84:87], v69, s[8:11], s84 offen nt
    s_add_u32 s84, s84, 4096
    s_and_b32 s84, s84, 0xffff
    buffer_load_dwordx4 v[88:91], v69, s[8:11], s84 offen nt
    s_add_u32 s84, s84, 4096
    s_and_b32 s84, s84, 0xffff
    buffer_load_dwordx4 v[92:95], v69, s[8:11], s84 offen nt
    s_add_u32 s84, s84, 4096
    s_and_b32 s84, s84, 0xffff
    buffer_load_dwordx4 v[96:99], v69, s[8:11], s84 offen nt
    s_add_u32 s84, s84, 4096
    s_and_b32 s84, s84, 0xffff
    s_branch L_kv2
L_q2:
    s_load_dword s66, s[32:33], 0
    s_mov_b32 s34, 2097152
    s_mov_b32 s35, 0x20000
    v_and_b32 v20, 1, v0
    v_bfe_u32 v21, v0, 1, 2
    v_cmp_eq_u32 vcc, 1, v20
    v_mov_b32 v22, 0x0c0c0100
    v_mov_b32 v23, 0x01000c0c
    v_cndmask_b32 v22, v22, v23, vcc
    v_mov_b32 v23, 0x0c0c0302
    v_mov_b32 v24, 0x03020c0c
    v_cndmask_b32 v23, v23, v24, vcc
    v_mov_b32 v24, 0x0c0c0c0c
    v_cmp_eq_u32 vcc, 0, v21
    s_nop 1
    v_cndmask_b32 v12, v24, v22, vcc
    v_cndmask_b32 v16, v24, v23, vcc
    v_cmp_eq_u32 vcc, 1, v21
    s_nop 1
    v_cndmask_b32 v13, v24, v22, vcc
    v_cndmask_b32 v17, v24, v23, vcc
    v_cmp_eq_u32 vcc, 2, v21
    s_nop 1
    v_cndmask_b32 v14, v24, v22, vcc
    v_cndmask_b32 v18, v24, v23, vcc
    v_cmp_eq_u32 vcc, 3, v21
    s_nop 1
    v_cndmask_b32 v15, v24, v22, vcc
    v_cndmask_b32 v19, v24, v23, vcc
    v_mov_b32 v5, 0x3b000000
    s_getreg_b32 s44, hwreg(HW_REG_XCC_ID, 0, 3)
    s_lshl_b32 s40, s44, 2
    s_and_b32 s40, s40, 4
    s_lshl_b32 s41, s44, 1
    s_and_b32 s41, s41, 4
    s_and_b32 s42, s44, 4
    s_lshl_b32 s62, s4, 13
    s_add_u32 s62, s62, 4096
    s_lshl_b32 s7, s5, 10
    s_add_u32 s63, s62, s7
    s_add_u32 s67, s62, 4096
    s_waitcnt vmcnt(16)
    v_lshlrev_b32 v20, 16, v8
    v_and_b32 v21, 0xffff0000, v8
    v_lshlrev_b32 v22, 16, v9
    v_and_b32 v23, 0xffff0000, v9
    v_lshlrev_b32 v24, 16, v10
    v_and_b32 v25, 0xffff0000, v10
    v_lshlrev_b32 v26, 16, v11
    v_and_b32 v27, 0xffff0000, v11
    v_add_f32 v1, v20, v21
    v_add_f32 v2, v22, v23
    v_add_f32 v3, v24, v25
    v_add_f32 v28, v26, v27
    v_add_f32 v1, v1, v2
    v_add_f32 v3, v3, v28
    v_add_f32 v1, v1, v3
    s_nop 1
    v_add_f32_dpp v1, v1, v1 quad_perm:[1,0,3,2] row_mask:0xf bank_mask:0xf
    s_nop 1
    v_add_f32_dpp v1, v1, v1 quad_perm:[2,3,0,1] row_mask:0xf bank_mask:0xf
    s_nop 1
    v_add_f32_dpp v1, v1, v1 row_half_mirror row_mask:0xf bank_mask:0xf
    s_nop 1
    v_add_f32_dpp v1, v1, v1 row_mirror row_mask:0xf bank_mask:0xf
    s_nop 1
    v_add_f32_dpp v1, v1, v1 row_bcast:15 row_mask:0xa bank_mask:0xf
    s_nop 1
    v_add_f32_dpp v1, v1, v1 row_bcast:31 row_mask:0xc bank_mask:0xf
    s_nop 0
    v_readlane_b32 s60, v1, 63
    s_nop 1
    v_mul_f32 v2, s60, v5
    v_sub_f32 v28, v20, v2
    v_sub_f32 v29, v21, v2
    v_sub_f32 v30, v22, v2
    v_sub_f32 v31, v23, v2
    v_sub_f32 v32, v24, v2
    v_sub_f32 v33, v25, v2
    v_sub_f32 v34, v26, v2
    v_sub_f32 v35, v27, v2
    v_cvt_pk_bf16_f32 v2, v2, v2
    v_mul_f32 v1, v28, v28
    v_mul_f32 v3, v29, v29
    v_lshlrev_b32 v2, 16, v2
    v_fmac_f32 v1, v30, v30
    v_fmac_f32 v3, v31, v31
    v_fmac_f32 v1, v32, v32
    v_fmac_f32 v3, v33, v33
    v_fmac_f32 v1, v34, v34
    v_fmac_f32 v3, v35, v35
    v_add_f32 v1, v1, v3
    v_sub_f32 v20, v20, v2
    v_sub_f32 v21, v21, v2
    v_sub_f32 v22, v22, v2
    v_sub_f32 v23, v23, v2
    v_sub_f32 v24, v24, v2
    v_sub_f32 v25, v25, v2
    v_sub_f32 v26, v26, v2
    v_sub_f32 v27, v27, v2
    s_nop 1
    v_add_f32_dpp v1, v1, v1 quad_perm:[1,0,3,2] row_mask:0xf bank_mask:0xf
    s_nop 1
    v_add_f32_dpp v1, v1, v1 quad_perm:[2,3,0,1] row_mask:0xf bank_mask:0xf
    s_nop 1
    v_add_f32_dpp v1, v1, v1 row_half_mirror row_mask:0xf bank_mask:0xf
    s_nop 1
    v_add_f32_dpp v1, v1, v1 row_mirror row_mask:0xf bank_mask:0xf
    s_nop 1
    v_add_f32_dpp v1, v1, v1 row_bcast:15 row_mask:0xa bank_mask:0xf
    s_nop 1
    v_add_f32_dpp v1, v1, v1 row_bcast:31 row_mask:0xc bank_mask:0xf
    s_nop 0
    v_readlane_b32 s61, v1, 63
    v_cvt_pk_bf16_f32 v28, v20, v21
    v_cvt_pk_bf16_f32 v29, v22, v23
    v_mul_f32 v1, s61, v5
    v_cvt_pk_bf16_f32 v30, v24, v25
    v_cvt_pk_bf16_f32 v31, v26, v27
    v_cvt_pk_bf16_f32 v1, v1, v1
    v_lshlrev_b32 v20, 16, v28
    v_lshlrev_b32 v1, 16, v1
    v_and_b32 v21, 0xffff0000, v28
    v_add_f32 v1, 0x3727c5ac, v1
    v_lshlrev_b32 v22, 16, v29
    v_cvt_pk_bf16_f32 v1, v1, v1
    v_and_b32 v23, 0xffff0000, v29
    v_lshlrev_b32 v1, 16, v1
    v_lshlrev_b32 v24, 16, v30
    v_sqrt_f32 v1, v1
    v_and_b32 v25, 0xffff0000, v30
    v_cvt_pk_bf16_f32 v1, v1, v1
    v_lshlrev_b32 v26, 16, v31
    v_lshlrev_b32 v1, 16, v1
    v_and_b32 v27, 0xffff0000, v31
    v_rcp_f32 v1, v1
    s_nop 0
    v_mul_f32 v20, v20, v1
    v_mul_f32 v21, v21, v1
    v_mul_f32 v22, v22, v1
    v_mul_f32 v23, v23, v1
    v_mul_f32 v24, v24, v1
    v_mul_f32 v25, v25, v1
    v_mul_f32 v26, v26, v1
    v_mul_f32 v27, v27, v1
    v_cvt_pk_bf16_f32 v36, v20, v21
    v_cvt_pk_bf16_f32 v37, v22, v23
    v_cvt_pk_bf16_f32 v38, v24, v25
    v_cvt_pk_bf16_f32 v39, v26, v27
    s_nop 0
    v_mov_b32_dpp v44, v36 row_newbcast:0 row_mask:0xf bank_mask:0xf
    v_mov_b32_dpp v45, v37 row_newbcast:0 row_mask:0xf bank_mask:0xf
    v_mov_b32_dpp v46, v38 row_newbcast:0 row_mask:0xf bank_mask:0xf
    v_mov_b32_dpp v47, v39 row_newbcast:0 row_mask:0xf bank_mask:0xf
    v_mov_b32_dpp v48, v36 row_newbcast:1 row_mask:0xf bank_mask:0xf
    v_mov_b32_dpp v49, v37 row_newbcast:1 row_mask:0xf bank_mask:0xf
    v_mov_b32_dpp v50, v38 row_newbcast:1 row_mask:0xf bank_mask:0xf
    v_mov_b32_dpp v51, v39 row_newbcast:1 row_mask:0xf bank_mask:0xf
    v_perm_b32 v52, v44, v44, v12
    v_perm_b32 v53, v44, v44, v13
    v_perm_b32 v54, v44, v44, v14
    v_perm_b32 v55, v44, v44, v15
    v_perm_b32 v56, v44, v44, v16
    v_perm_b32 v57, v44, v44, v17
    v_perm_b32 v58, v44, v44, v18
    v_perm_b32 v59, v44, v44, v19
    s_waitcnt vmcnt(15)
    v_mfma_f32_16x16x32_bf16 v[60:63], v[52:55], v[76:79], 0
    v_perm_b32 v52, v45, v45, v12
    v_perm_b32 v53, v45, v45, v13
    v_perm_b32 v54, v45, v45, v14
    v_perm_b32 v55, v45, v45, v15
    s_waitcnt vmcnt(14)
    v_mfma_f32_16x16x32_bf16 v[60:63], v[56:59], v[80:83], v[60:63]
    v_perm_b32 v56, v45, v45, v16
    v_perm_b32 v57, v45, v45, v17
    v_perm_b32 v58, v45, v45, v18
    v_perm_b32 v59, v45, v45, v19
    s_waitcnt vmcnt(13)
    v_mfma_f32_16x16x32_bf16 v[60:63], v[52:55], v[84:87], v[60:63]
    v_perm_b32 v52, v46, v46, v12
    v_perm_b32 v53, v46, v46, v13
    v_perm_b32 v54, v46, v46, v14
    v_perm_b32 v55, v46, v46, v15
    s_waitcnt vmcnt(12)
    v_mfma_f32_16x16x32_bf16 v[60:63], v[56:59], v[88:91], v[60:63]
    v_perm_b32 v56, v46, v46, v16
    v_perm_b32 v57, v46, v46, v17
    v_perm_b32 v58, v46, v46, v18
    v_perm_b32 v59, v46, v46, v19
    s_waitcnt vmcnt(11)
    v_mfma_f32_16x16x32_bf16 v[60:63], v[52:55], v[92:95], v[60:63]
    v_perm_b32 v52, v47, v47, v12
    v_perm_b32 v53, v47, v47, v13
    v_perm_b32 v54, v47, v47, v14
    v_perm_b32 v55, v47, v47, v15
    s_waitcnt vmcnt(10)
    v_mfma_f32_16x16x32_bf16 v[60:63], v[56:59], v[96:99], v[60:63]
    v_perm_b32 v56, v47, v47, v16
    v_perm_b32 v57, v47, v47, v17
    v_perm_b32 v58, v47, v47, v18
    v_perm_b32 v59, v47, v47, v19
    s_waitcnt vmcnt(9)
    v_mfma_f32_16x16x32_bf16 v[60:63], v[52:55], v[100:103], v[60:63]
    v_perm_b32 v52, v48, v48, v12
    v_perm_b32 v53, v48, v48, v13
    v_perm_b32 v54, v48, v48, v14
    v_perm_b32 v55, v48, v48, v15
    s_waitcnt vmcnt(8)
    v_mfma_f32_16x16x32_bf16 v[60:63], v[56:59], v[104:107], v[60:63]
    v_perm_b32 v56, v48, v48, v16
    v_perm_b32 v57, v48, v48, v17
    v_perm_b32 v58, v48, v48, v18
    v_perm_b32 v59, v48, v48, v19
    s_waitcnt vmcnt(7)
    v_mfma_f32_16x16x32_bf16 v[60:63], v[52:55], v[108:111], v[60:63]
    v_perm_b32 v52, v49, v49, v12
    v_perm_b32 v53, v49, v49, v13
    v_perm_b32 v54, v49, v49, v14
    v_perm_b32 v55, v49, v49, v15
    s_waitcnt vmcnt(6)
    v_mfma_f32_16x16x32_bf16 v[60:63], v[56:59], v[112:115], v[60:63]
    v_perm_b32 v56, v49, v49, v16
    v_perm_b32 v57, v49, v49, v17
    v_perm_b32 v58, v49, v49, v18
    v_perm_b32 v59, v49, v49, v19
    s_waitcnt vmcnt(5)
    v_mfma_f32_16x16x32_bf16 v[60:63], v[52:55], v[116:119], v[60:63]
    v_perm_b32 v52, v50, v50, v12
    v_perm_b32 v53, v50, v50, v13
    v_perm_b32 v54, v50, v50, v14
    v_perm_b32 v55, v50, v50, v15
    s_waitcnt vmcnt(4)
    v_mfma_f32_16x16x32_bf16 v[60:63], v[56:59], v[120:123], v[60:63]
    v_perm_b32 v56, v50, v50, v16
    v_perm_b32 v57, v50, v50, v17
    v_perm_b32 v58, v50, v50, v18
    v_perm_b32 v59, v50, v50, v19
    s_waitcnt vmcnt(3)
    v_mfma_f32_16x16x32_bf16 v[60:63], v[52:55], v[124:127], v[60:63]
    v_perm_b32 v52, v51, v51, v12
    v_perm_b32 v53, v51, v51, v13
    v_perm_b32 v54, v51, v51, v14
    v_perm_b32 v55, v51, v51, v15
    s_waitcnt vmcnt(2)
    v_mfma_f32_16x16x32_bf16 v[60:63], v[56:59], v[128:131], v[60:63]
    v_perm_b32 v56, v51, v51, v16
    v_perm_b32 v57, v51, v51, v17
    v_perm_b32 v58, v51, v51, v18
    v_perm_b32 v59, v51, v51, v19
    s_waitcnt vmcnt(1)
    v_mfma_f32_16x16x32_bf16 v[60:63], v[52:55], v[132:135], v[60:63]
    s_waitcnt lgkmcnt(0)
    s_add_u32 s66, s66, 0x9e3779b9
    v_and_b32 v1, 3, v0
    v_lshlrev_b32 v1, 3, v1
    v_lshrrev_b32 v1, v1, s66
    s_waitcnt vmcnt(0)
    v_mfma_f32_16x16x32_bf16 v[60:63], v[56:59], v[136:139], v[60:63]
    v_and_b32 v120, 3, v1
    v_bfe_u32 v121, v1, 2, 2
    v_bfe_u32 v122, v1, 4, 2
    v_bfe_u32 v123, v1, 6, 2
    v_or_b32 v120, s40, v120
    v_or_b32 v121, s41, v121
    v_or_b32 v122, s42, v122
    v_lshlrev_b32 v124, 4, v0
    s_cmp_lt_u32 s4, 12
    s_cselect_b32 s64, 6, 5
    s_mov_b32 exec_hi, 0
    v_add_u32 v128, 4, v60
    v_add_u32 v129, 4, v61
    v_add_u32 v130, 4, v62
    v_add_u32 v131, 4, v63
    v_bfi_b32 v128, 7, v120, v128
    v_bfi_b32 v129, 7, v121, v129
    v_bfi_b32 v130, 7, v122, v130
    v_bfi_b32 v131, 7, v123, v131
    buffer_store_dwordx4 v[128:131], v124, s[32:35], s63 offen
    s_mov_b32 exec_hi, -1
    s_cmp_lt_u32 s4, 12
    s_cselect_b32 s64, 6, 5
    v_bfe_u32 v3, v0, 3, 1
    v_lshl_add_u32 v3, v6, 4, v3
    v_mul_u32_u24 v3, 2752, v3
    v_and_b32 v4, 7, v0
    v_lshl_add_u32 v3, v4, 4, v3
    v_cmp_gt_u32 vcc, s64, v4
    v_mov_b32 v1, 0x40000000
    s_mul_i32 s61, s5, 176128
    v_cndmask_b32 v3, v1, v3, vcc
    s_lshl_b32 s7, s6, 4
    s_add_u32 s61, s61, s7
    s_mov_b32 s14, 1409024
    s_mov_b64 s[12:13], s[48:49]
    buffer_load_dwordx4 v[140:143], v3, s[12:15], s61 offen
    s_add_u32 s61, s61, 5504
    buffer_load_dwordx4 v[144:147], v3, s[12:15], s61 offen
    s_add_u32 s61, s61, 5504
    buffer_load_dwordx4 v[148:151], v3, s[12:15], s61 offen
    s_add_u32 s61, s61, 5504
    buffer_load_dwordx4 v[152:155], v3, s[12:15], s61 offen
    s_add_u32 s61, s61, 5504
    buffer_load_dwordx4 v[156:159], v3, s[12:15], s61 offen
    s_add_u32 s61, s61, 5504
    buffer_load_dwordx4 v[160:163], v3, s[12:15], s61 offen
    s_add_u32 s61, s61, 5504
    buffer_load_dwordx4 v[164:167], v3, s[12:15], s61 offen
    s_add_u32 s61, s61, 5504
    buffer_load_dwordx4 v[168:171], v3, s[12:15], s61 offen
    s_mov_b32 s18, 2752
    s_mov_b32 s19, 0x20000
    s_mov_b32 s22, 1024
    s_mov_b32 s23, 0x20000
    s_mov_b32 s26, 1024
    s_mov_b32 s27, 0x20000
    s_mov_b32 s30, 1024
    s_mov_b32 s31, 0x20000
    s_mov_b64 s[16:17], s[50:51]
    s_mov_b64 s[20:21], s[54:55]
    s_mov_b64 s[24:25], s[36:37]
    s_mov_b64 s[28:29], s[56:57]
    v_and_b32 v4, 7, v0
    s_lshl_b32 s7, s6, 4
    v_bfe_u32 v1, v0, 3, 1
    v_lshl_add_u32 v1, v1, 2, v6
    v_lshl_add_u32 v1, v4, 3, v1
    v_lshlrev_b32 v69, 1, v1
    buffer_load_ushort v68, v69, s[16:19], s7 offen
    s_and_b32 s47, s2, 7
    s_lshl_b32 s47, s47, 3
    s_lshr_b32 s7, s2, 3
    s_add_u32 s47, s47, s7
    v_lshlrev_b32 v72, 1, v4
    s_lshl_b32 s7, s47, 4
    v_add_u32 v72, s7, v72
    buffer_load_ushort v70, v72, s[24:27], 0 offen
    buffer_load_ushort v71, v72, s[20:23], 0 offen
    s_mov_b64 exec, -1
    v_lshrrev_b32 v73, 3, v0
    v_lshlrev_b32 v73, 8, v73
    v_lshl_add_u32 v73, v4, 4, v73
    s_lshr_b32 s65, s47, 1
    s_lshl_b32 s65, s65, 13
    s_and_b32 s7, s47, 1
    s_lshl_b32 s7, s7, 7
    s_add_u32 s65, s65, s7
    s_add_u32 s65, s65, 397312
    s_add_u32 s69, s65, 4096
    v_lshlrev_b32 v20, 16, v36
    v_and_b32 v21, 0xffff0000, v36
    v_lshlrev_b32 v22, 16, v37
    v_and_b32 v23, 0xffff0000, v37
    v_lshlrev_b32 v24, 16, v38
    v_and_b32 v25, 0xffff0000, v38
    v_lshlrev_b32 v26, 16, v39
    v_and_b32 v27, 0xffff0000, v39
    v_add_f32 v1, v20, v21
    v_add_f32 v2, v22, v23
    v_add_f32 v3, v24, v25
    v_add_f32 v28, v26, v27
    v_add_f32 v1, v1, v2
    v_add_f32 v3, v3, v28
    v_add_f32 v1, v1, v3
    s_nop 1
    v_add_f32_dpp v1, v1, v1 quad_perm:[1,0,3,2] row_mask:0xf bank_mask:0xf
    s_nop 1
    v_add_f32_dpp v1, v1, v1 quad_perm:[2,3,0,1] row_mask:0xf bank_mask:0xf
    s_nop 1
    v_add_f32_dpp v1, v1, v1 row_half_mirror row_mask:0xf bank_mask:0xf
    s_nop 1
    v_add_f32_dpp v1, v1, v1 row_mirror row_mask:0xf bank_mask:0xf
    s_nop 1
    v_add_f32_dpp v1, v1, v1 row_bcast:15 row_mask:0xa bank_mask:0xf
    s_nop 1
    v_add_f32_dpp v1, v1, v1 row_bcast:31 row_mask:0xc bank_mask:0xf
    s_nop 0
    v_readlane_b32 s60, v1, 63
    s_nop 1
    v_mul_f32 v2, s60, v5
    v_sub_f32 v28, v20, v2
    v_sub_f32 v29, v21, v2
    v_sub_f32 v30, v22, v2
    v_sub_f32 v31, v23, v2
    v_sub_f32 v32, v24, v2
    v_sub_f32 v33, v25, v2
    v_sub_f32 v34, v26, v2
    v_sub_f32 v35, v27, v2
    v_cvt_pk_bf16_f32 v2, v2, v2
    v_mul_f32 v1, v28, v28
    v_mul_f32 v3, v29, v29
    v_lshlrev_b32 v2, 16, v2
    v_fmac_f32 v1, v30, v30
    v_fmac_f32 v3, v31, v31
    v_fmac_f32 v1, v32, v32
    v_fmac_f32 v3, v33, v33
    v_fmac_f32 v1, v34, v34
    v_fmac_f32 v3, v35, v35
    v_add_f32 v1, v1, v3
    v_sub_f32 v20, v20, v2
    v_sub_f32 v21, v21, v2
    v_sub_f32 v22, v22, v2
    v_sub_f32 v23, v23, v2
    v_sub_f32 v24, v24, v2
    v_sub_f32 v25, v25, v2
    v_sub_f32 v26, v26, v2
    v_sub_f32 v27, v27, v2
    s_nop 1
    v_add_f32_dpp v1, v1, v1 quad_perm:[1,0,3,2] row_mask:0xf bank_mask:0xf
    s_nop 1
    v_add_f32_dpp v1, v1, v1 quad_perm:[2,3,0,1] row_mask:0xf bank_mask:0xf
    s_nop 1
    v_add_f32_dpp v1, v1, v1 row_half_mirror row_mask:0xf bank_mask:0xf
    s_nop 1
    v_add_f32_dpp v1, v1, v1 row_mirror row_mask:0xf bank_mask:0xf
    s_nop 1
    v_add_f32_dpp v1, v1, v1 row_bcast:15 row_mask:0xa bank_mask:0xf
    s_nop 1
    v_add_f32_dpp v1, v1, v1 row_bcast:31 row_mask:0xc bank_mask:0xf
    s_nop 0
    v_readlane_b32 s61, v1, 63
    v_cvt_pk_bf16_f32 v28, v20, v21
    v_cvt_pk_bf16_f32 v29, v22, v23
    v_mul_f32 v1, s61, v5
    v_cvt_pk_bf16_f32 v30, v24, v25
    v_cvt_pk_bf16_f32 v31, v26, v27
    v_cvt_pk_bf16_f32 v1, v1, v1
    v_lshlrev_b32 v20, 16, v28
    v_lshlrev_b32 v1, 16, v1
    v_and_b32 v21, 0xffff0000, v28
    v_add_f32 v1, 0x3727c5ac, v1
    v_lshlrev_b32 v22, 16, v29
    v_cvt_pk_bf16_f32 v1, v1, v1
    v_and_b32 v23, 0xffff0000, v29
    v_lshlrev_b32 v1, 16, v1
    v_lshlrev_b32 v24, 16, v30
    v_sqrt_f32 v1, v1
    v_and_b32 v25, 0xffff0000, v30
    v_cvt_pk_bf16_f32 v1, v1, v1
    v_lshlrev_b32 v26, 16, v31
    v_lshlrev_b32 v1, 16, v1
    v_and_b32 v27, 0xffff0000, v31
    v_rcp_f32 v1, v1
    s_nop 0
    v_mul_f32 v20, v20, v1
    v_mul_f32 v21, v21, v1
    v_mul_f32 v22, v22, v1
    v_mul_f32 v23, v23, v1
    v_mul_f32 v24, v24, v1
    v_mul_f32 v25, v25, v1
    v_mul_f32 v26, v26, v1
    v_mul_f32 v27, v27, v1
    v_cvt_pk_bf16_f32 v40, v20, v21
    v_cvt_pk_bf16_f32 v41, v22, v23
    v_cvt_pk_bf16_f32 v42, v24, v25
    v_cvt_pk_bf16_f32 v43, v26, v27
    s_nop 0
    v_mov_b32_dpp v44, v40 row_newbcast:0 row_mask:0xf bank_mask:0xf
    v_mov_b32_dpp v45, v41 row_newbcast:0 row_mask:0xf bank_mask:0xf
    v_mov_b32_dpp v46, v42 row_newbcast:0 row_mask:0xf bank_mask:0xf
    v_mov_b32_dpp v47, v43 row_newbcast:0 row_mask:0xf bank_mask:0xf
    v_mov_b32_dpp v48, v40 row_newbcast:1 row_mask:0xf bank_mask:0xf
    v_mov_b32_dpp v49, v41 row_newbcast:1 row_mask:0xf bank_mask:0xf
    v_mov_b32_dpp v50, v42 row_newbcast:1 row_mask:0xf bank_mask:0xf
    v_mov_b32_dpp v51, v43 row_newbcast:1 row_mask:0xf bank_mask:0xf
    v_mov_b32_dpp v12, v16 quad_perm:[0,1,2,3] row_mask:0xf bank_mask:0xc
    v_mov_b32_dpp v13, v17 quad_perm:[0,1,2,3] row_mask:0xf bank_mask:0xc
    v_mov_b32_dpp v14, v18 quad_perm:[0,1,2,3] row_mask:0xf bank_mask:0xc
    v_mov_b32_dpp v15, v19 quad_perm:[0,1,2,3] row_mask:0xf bank_mask:0xc
    v_lshrrev_b32 v1, 5, v0
    v_and_b32 v2, 31, v0
    v_lshlrev_b32 v2, 4, v2
    v_lshl_add_u32 v2, v1, 10, v2
    v_lshlrev_b32 v3, 4, v7
    v_lshl_add_u32 v3, v6, 10, v3
    v_lshlrev_b32 v4, 3, v6
    v_add_lshl_u32 v4, v4, v7, 4
    s_mov_b32 s68, 1048576
    s_waitcnt vmcnt(11)
    buffer_load_dwordx4 v[76:79], v2, s[32:35], s62 offen offset:0 sc1
    buffer_load_dwordx4 v[80:83], v2, s[32:35], s62 offen offset:2048 sc1
    buffer_load_dwordx4 v[84:87], v2, s[32:35], s67 offen offset:0 sc1
    buffer_load_dwordx4 v[88:91], v2, s[32:35], s67 offen offset:2048 sc1
    v_perm_b32 v52, v44, v44, v12
    v_perm_b32 v53, v44, v44, v13
    v_perm_b32 v54, v44, v44, v14
    v_perm_b32 v55, v44, v44, v15
    s_waitcnt vmcnt(14)
    s_nop 0
    v_mfma_f32_16x16x32_bf16 v[64:67], v[52:55], v[140:143], 0
    v_perm_b32 v56, v45, v45, v12
    v_perm_b32 v57, v45, v45, v13
    v_perm_b32 v58, v45, v45, v14
    v_perm_b32 v59, v45, v45, v15
    s_waitcnt vmcnt(13)
    s_nop 0
    v_mfma_f32_16x16x32_bf16 v[64:67], v[56:59], v[144:147], v[64:67]
    v_perm_b32 v52, v46, v46, v12
    v_perm_b32 v53, v46, v46, v13
    v_perm_b32 v54, v46, v46, v14
    v_perm_b32 v55, v46, v46, v15
    s_waitcnt vmcnt(12)
    s_nop 0
    v_mfma_f32_16x16x32_bf16 v[64:67], v[52:55], v[148:151], v[64:67]
    v_perm_b32 v56, v47, v47, v12
    v_perm_b32 v57, v47, v47, v13
    v_perm_b32 v58, v47, v47, v14
    v_perm_b32 v59, v47, v47, v15
    s_waitcnt vmcnt(11)
    s_nop 0
    v_mfma_f32_16x16x32_bf16 v[64:67], v[56:59], v[152:155], v[64:67]
    v_perm_b32 v52, v48, v48, v12
    v_perm_b32 v53, v48, v48, v13
    v_perm_b32 v54, v48, v48, v14
    v_perm_b32 v55, v48, v48, v15
    s_waitcnt vmcnt(10)
    s_nop 0
    v_mfma_f32_16x16x32_bf16 v[64:67], v[52:55], v[156:159], v[64:67]
    v_perm_b32 v56, v49, v49, v12
    v_perm_b32 v57, v49, v49, v13
    v_perm_b32 v58, v49, v49, v14
    v_perm_b32 v59, v49, v49, v15
    s_waitcnt vmcnt(9)
    s_nop 0
    v_mfma_f32_16x16x32_bf16 v[64:67], v[56:59], v[160:163], v[64:67]
    v_perm_b32 v52, v50, v50, v12
    v_perm_b32 v53, v50, v50, v13
    v_perm_b32 v54, v50, v50, v14
    v_perm_b32 v55, v50, v50, v15
    s_waitcnt vmcnt(8)
    s_nop 0
    v_mfma_f32_16x16x32_bf16 v[64:67], v[52:55], v[164:167], v[64:67]
    v_perm_b32 v56, v51, v51, v12
    v_perm_b32 v57, v51, v51, v13
    v_perm_b32 v58, v51, v51, v14
    v_perm_b32 v59, v51, v51, v15
    s_waitcnt vmcnt(7)
    s_nop 0
    v_mfma_f32_16x16x32_bf16 v[64:67], v[56:59], v[168:171], v[64:67]
    s_nop 7
    v_mov_b32 v20, v64
    v_mov_b32 v21, v65
    v_mov_b32 v22, v66
    v_mov_b32 v23, v67
    v_permlane32_swap_b32 v64, v20
    v_permlane32_swap_b32 v65, v21
    v_permlane32_swap_b32 v66, v22
    v_permlane32_swap_b32 v67, v23
    v_add_f32_dpp v64, v20, v64 row_ror:8 row_mask:0xf bank_mask:0xf
    v_add_f32_dpp v65, v21, v65 row_ror:8 row_mask:0xf bank_mask:0xf
    v_add_f32_dpp v66, v22, v66 row_ror:8 row_mask:0xf bank_mask:0xf
    v_add_f32_dpp v67, v23, v67 row_ror:8 row_mask:0xf bank_mask:0xf
    v_add_u32 v64, 4, v64
    v_add_u32 v65, 4, v65
    v_add_u32 v66, 4, v66
    v_add_u32 v67, 4, v67
    v_bfi_b32 v64, 7, v120, v64
    v_bfi_b32 v65, 7, v121, v65
    v_bfi_b32 v66, 7, v122, v66
    v_bfi_b32 v67, 7, v123, v67
    s_mov_b64 exec, 0x00ff00ff
    buffer_store_dwordx4 v[64:67], v4, s[32:35], s63 offen offset:512
L_g0c:
    s_mov_b64 exec, -1
    s_waitcnt vmcnt(4)
    v_xor_b32 v1, v120, v76
    v_and_b32 v76, -8, v76
    v_bitop3_b32 v1, v1, v77, v121 bitop3:0xf6
    v_and_b32 v77, -8, v77
    v_bitop3_b32 v1, v1, v78, v122 bitop3:0xf6
    v_and_b32 v78, -8, v78
    v_bitop3_b32 v1, v1, v79, v123 bitop3:0xf6
    v_and_b32 v79, -8, v79
    s_waitcnt vmcnt(3)
    v_bitop3_b32 v1, v1, v80, v120 bitop3:0xf6
    v_and_b32 v80, -8, v80
    v_bitop3_b32 v1, v1, v81, v121 bitop3:0xf6
    v_and_b32 v81, -8, v81
    v_bitop3_b32 v1, v1, v82, v122 bitop3:0xf6
    v_and_b32 v82, -8, v82
    v_bitop3_b32 v1, v1, v83, v123 bitop3:0xf6
    v_and_b32 v83, -8, v83
    v_add_f32 v60, v76, v80
    v_add_f32 v61, v77, v81
    v_add_f32 v62, v78, v82
    v_add_f32 v63, v79, v83
    s_waitcnt vmcnt(2)
    v_bitop3_b32 v1, v1, v84, v120 bitop3:0xf6
    v_and_b32 v84, -8, v84
    v_bitop3_b32 v1, v1, v85, v121 bitop3:0xf6
    v_and_b32 v85, -8, v85
    v_bitop3_b32 v1, v1, v86, v122 bitop3:0xf6
    v_and_b32 v86, -8, v86
    v_bitop3_b32 v1, v1, v87, v123 bitop3:0xf6
    v_and_b32 v87, -8, v87
    v_add_f32 v60, v60, v84
    v_add_f32 v61, v61, v85
    v_add_f32 v62, v62, v86
    v_add_f32 v63, v63, v87
    s_waitcnt vmcnt(1)
    v_bitop3_b32 v1, v1, v88, v120 bitop3:0xf6
    v_and_b32 v88, -8, v88
    v_bitop3_b32 v1, v1, v89, v121 bitop3:0xf6
    v_and_b32 v89, -8, v89
    v_bitop3_b32 v1, v1, v90, v122 bitop3:0xf6
    v_and_b32 v90, -8, v90
    v_bitop3_b32 v1, v1, v91, v123 bitop3:0xf6
    v_and_b32 v91, -8, v91
    v_add_f32 v60, v60, v88
    v_add_f32 v61, v61, v89
    v_add_f32 v62, v62, v90
    v_add_f32 v63, v63, v91
    v_and_b32 v20, 3, v1
    v_cmp_ne_u32 vcc, 0, v20
    s_sub_u32 s68, s68, 1
    s_cbranch_scc1 L_g0done
    s_cbranch_vccz L_g0done
    s_cmp_le_u32 s68, 1048573
    s_cbranch_scc1 L_g0far
    buffer_load_dwordx4 v[76:79], v2, s[32:35], s62 offen offset:0 sc1
    buffer_load_dwordx4 v[80:83], v2, s[32:35], s62 offen offset:2048 sc1
    buffer_load_dwordx4 v[84:87], v2, s[32:35], s67 offen offset:0 sc1
    buffer_load_dwordx4 v[88:91], v2, s[32:35], s67 offen offset:2048 sc1
    s_mov_b64 exec, 0x00ff00ff
    buffer_store_dwordx4 v[64:67], v4, s[32:35], s63 offen offset:512
    s_branch L_g0c
L_g0far:
    s_mov_b32 exec_hi, 0
    buffer_store_dwordx4 v[128:131], v124, s[32:35], s63 offen sc1
    s_mov_b32 exec_hi, -1
    buffer_load_dwordx4 v[76:79], v2, s[32:35], s62 offen offset:0 sc1
    buffer_load_dwordx4 v[80:83], v2, s[32:35], s62 offen offset:2048 sc1
    buffer_load_dwordx4 v[84:87], v2, s[32:35], s67 offen offset:0 sc1
    buffer_load_dwordx4 v[88:91], v2, s[32:35], s67 offen offset:2048 sc1
    s_mov_b64 exec, 0x00ff00ff
    buffer_store_dwordx4 v[64:67], v4, s[32:35], s63 offen offset:512 sc1
    s_branch L_g0c
L_g0done:
    v_and_b32 v20, 4, v1
    v_cmp_ne_u32 vcc, 0, v20
    s_mov_b32 s45, 1
    s_cbranch_vccz L_near
    s_mov_b32 s45, 0
    s_mov_b32 exec_hi, 0
    buffer_store_dwordx4 v[128:131], v124, s[32:35], s63 offen sc1
    s_mov_b64 exec, 0x00ff00ff
    buffer_store_dwordx4 v[64:67], v4, s[32:35], s63 offen offset:512 sc1
    s_mov_b64 exec, -1
L_near:
    v_permlane32_swap_b32 v60, v62
    v_permlane32_swap_b32 v61, v63
    v_add_f32 v60, v60, v62
    v_add_f32 v61, v61, v63
    v_and_b32 v1, 1, v6
    v_lshlrev_b32 v1, 3, v1
    v_lshl_add_u32 v1, v7, 4, v1
    v_lshrrev_b32 v2, 5, v0
    v_lshl_add_u32 v1, v2, 2, v1
    v_cvt_pk_bf16_f32 v20, v60, v61
    ds_write_b32 v1, v20 offset:24576
    s_mov_b32 s68, 1048576
    v_mov_b32 v1, 0
    v_mov_b32 v20, 1
    s_waitcnt lgkmcnt(0)
    ds_write_b32 v1, v20 offset:24992
    s_waitcnt vmcnt(0)
L_gh:
    buffer_load_dwordx4 v[76:79], v3, s[32:35], s62 offen offset:512 sc1
    buffer_load_dwordx4 v[80:83], v3, s[32:35], s67 offen offset:512 sc1
    s_waitcnt vmcnt(1)
    v_xor_b32 v1, v120, v76
    v_and_b32 v76, -8, v76
    v_bitop3_b32 v1, v1, v77, v121 bitop3:0xf6
    v_and_b32 v77, -8, v77
    v_bitop3_b32 v1, v1, v78, v122 bitop3:0xf6
    v_and_b32 v78, -8, v78
    v_bitop3_b32 v1, v1, v79, v123 bitop3:0xf6
    v_and_b32 v79, -8, v79
    s_waitcnt vmcnt(0)
    v_bitop3_b32 v1, v1, v80, v120 bitop3:0xf6
    v_and_b32 v80, -8, v80
    v_bitop3_b32 v1, v1, v81, v121 bitop3:0xf6
    v_and_b32 v81, -8, v81
    v_bitop3_b32 v1, v1, v82, v122 bitop3:0xf6
    v_and_b32 v82, -8, v82
    v_bitop3_b32 v1, v1, v83, v123 bitop3:0xf6
    v_and_b32 v83, -8, v83
    v_add_f32 v60, v76, v80
    v_add_f32 v61, v77, v81
    v_add_f32 v62, v78, v82
    v_add_f32 v63, v79, v83
    v_and_b32 v20, 3, v1
    v_cmp_ne_u32 vcc, 0, v20
    s_sub_u32 s68, s68, 1
    s_cbranch_scc1 L_ghdone
    s_cbranch_vccnz L_gh
L_ghdone:
    v_permlane32_swap_b32 v60, v62
    v_permlane32_swap_b32 v61, v63
    v_add_f32 v60, v60, v62
    v_add_f32 v61, v61, v63
    s_nop 0
    s_mov_b32 s7, 0xbdd2d3e8
    v_permlane16_swap_b32 v60, v61
    v_add_f32 v60, v60, v61
    v_lshlrev_b32 v68, 16, v68
    v_mov_b32 v30, 0xc0135761
    v_cvt_pk_bf16_f32 v22, v60, v60
    v_lshlrev_b32 v22, 16, v22
    v_add_f32 v22, v22, v68
    v_cvt_pk_bf16_f32 v22, v22, v22
    v_lshlrev_b32 v22, 16, v22
    v_mul_f32 v26, v22, v22
    v_fma_f32 v26, v26, s7, v30
    v_mul_f32 v26, v26, v22
    v_exp_f32 v26, v26
    v_and_b32 v4, 7, v0
    v_add_f32 v26, 1.0, v26
    v_rcp_f32 v26, v26
    v_cmp_gt_u32 vcc, s64, v4
    v_mul_f32 v26, v26, v22
    v_cvt_pk_bf16_f32 v20, v26, v26
    v_cndmask_b32 v20, 0, v20, vcc
    ds_write_b16 v69, v20 offset:24832
    v_bfe_u32 v2, v7, 1, 2
    v_lshlrev_b32 v2, 10, v2
    v_and_b32 v3, 1, v7
    v_lshl_add_u32 v2, v3, 9, v2
    v_and_b32 v3, 1, v6
    v_lshl_add_u32 v2, v3, 8, v2
    v_lshrrev_b32 v3, 3, v7
    v_lshl_add_u32 v2, v3, 7, v2
    s_lshl_b32 s62, s4, 12
    s_lshl_b32 s7, s5, 4
    s_add_u32 s62, s62, s7
    s_add_u32 s62, s62, 266240
    v_and_b32 v4, 31, v0
    v_lshlrev_b32 v4, 4, v4
    v_mov_b32 v1, 0
    v_mov_b32 v62, s66
    v_mov_b32 v60, s66
    s_mov_b32 exec_hi, 0
    s_cmp_eq_u32 s45, 1
    s_waitcnt lgkmcnt(0)
    s_barrier
    ds_read_b128 v[24:27], v1 offset:24960
    ds_read_b128 v[28:31], v1 offset:24976
    ds_read_b128 v[36:39], v4 offset:25024
    ds_read_b128 v[40:43], v4 offset:25536
    ds_read_b128 v[44:47], v4 offset:26048
    ds_read_b128 v[48:51], v4 offset:26560
    s_waitcnt lgkmcnt(4)
    v_max3_f32 v61, v24, v26, v28
    v_max_f32 v61, v61, v30
    v_sub_f32 v32, v24, v61
    v_sub_f32 v33, v26, v61
    v_sub_f32 v34, v28, v61
    v_sub_f32 v35, v30, v61
    v_exp_f32 v32, v32
    v_exp_f32 v33, v33
    v_exp_f32 v34, v34
    v_exp_f32 v35, v35
    s_waitcnt lgkmcnt(3)
    v_mul_f32 v20, v32, v36
    v_mul_f32 v21, v32, v37
    v_mul_f32 v22, v32, v38
    v_mul_f32 v23, v32, v39
    v_mul_f32 v63, v32, v25
    s_waitcnt lgkmcnt(2)
    v_fmac_f32 v20, v33, v40
    v_fmac_f32 v21, v33, v41
    v_fmac_f32 v22, v33, v42
    v_fmac_f32 v23, v33, v43
    v_fmac_f32 v63, v33, v27
    s_waitcnt lgkmcnt(1)
    v_fmac_f32 v20, v34, v44
    v_fmac_f32 v21, v34, v45
    v_fmac_f32 v22, v34, v46
    v_fmac_f32 v23, v34, v47
    v_fmac_f32 v63, v34, v29
    s_waitcnt lgkmcnt(0)
    v_fmac_f32 v20, v35, v48
    v_fmac_f32 v21, v35, v49
    v_fmac_f32 v22, v35, v50
    v_fmac_f32 v23, v35, v51
    v_fmac_f32 v63, v35, v31
    s_mov_b32 exec_lo, 0x33333333
    v_cvt_pk_bf16_f32 v62, v20, v21
    v_cvt_pk_bf16_f32 v63, v22, v23
    s_mov_b32 exec_lo, 0xcccccccc
    v_cvt_pk_bf16_f32 v60, v20, v21
    v_cvt_pk_bf16_f32 v61, v22, v23
    s_mov_b32 exec_lo, -1
    s_cbranch_scc0 L_far
    buffer_store_dwordx4 v[60:63], v2, s[32:35], s62 offen
    s_branch L_pub1
L_far:
    buffer_store_dwordx4 v[60:63], v2, s[32:35], s62 offen sc1
L_pub1:
    s_mov_b64 exec, -1
    s_mov_b32 s68, 1048576
    s_barrier
    s_barrier
    s_cmp_ge_u32 s2, 64
    s_cbranch_scc1 L_qend
    v_lshlrev_b32 v70, 16, v70
    v_lshlrev_b32 v71, 16, v71
    buffer_load_dwordx4 v[76:79], v73, s[32:35], s65 offen offset:0 sc1
    buffer_load_dwordx4 v[80:83], v73, s[32:35], s65 offen offset:2048 sc1
    buffer_load_dwordx4 v[84:87], v73, s[32:35], s69 offen offset:0 sc1
    buffer_load_dwordx4 v[88:91], v73, s[32:35], s69 offen offset:2048 sc1
L_ps:
    buffer_load_dwordx4 v[92:95], v73, s[32:35], s65 offen offset:0 sc1
    buffer_load_dwordx4 v[96:99], v73, s[32:35], s65 offen offset:2048 sc1
    buffer_load_dwordx4 v[100:103], v73, s[32:35], s69 offen offset:0 sc1
    buffer_load_dwordx4 v[104:107], v73, s[32:35], s69 offen offset:2048 sc1
    s_waitcnt vmcnt(4)
    v_xor_b32 v1, s66, v78
    v_bitop3_b32 v1, v1, v82, s66 bitop3:0xf6
    v_bitop3_b32 v1, v1, v86, s66 bitop3:0xf6
    v_bitop3_b32 v1, v1, v90, s66 bitop3:0xf6
    v_cmp_ne_u32 vcc, 0, v1
    v_add_f32 v20, v76, v80
    v_add_f32 v21, v77, v81
    v_add_f32 v22, v84, v88
    v_add_f32 v23, v85, v89
    s_cbranch_vccz L_psdone
    buffer_load_dwordx4 v[76:79], v73, s[32:35], s65 offen offset:0 sc1
    buffer_load_dwordx4 v[80:83], v73, s[32:35], s65 offen offset:2048 sc1
    buffer_load_dwordx4 v[84:87], v73, s[32:35], s69 offen offset:0 sc1
    buffer_load_dwordx4 v[88:91], v73, s[32:35], s69 offen offset:2048 sc1
    s_waitcnt vmcnt(4)
    v_xor_b32 v1, s66, v94
    v_bitop3_b32 v1, v1, v98, s66 bitop3:0xf6
    v_bitop3_b32 v1, v1, v102, s66 bitop3:0xf6
    v_bitop3_b32 v1, v1, v106, s66 bitop3:0xf6
    v_cmp_ne_u32 vcc, 0, v1
    v_add_f32 v20, v92, v96
    v_add_f32 v21, v93, v97
    v_add_f32 v22, v100, v104
    v_add_f32 v23, v101, v105
    s_sub_u32 s68, s68, 1
    s_cbranch_scc1 L_psdone
    s_cbranch_vccnz L_ps
L_psdone:
    v_add_f32 v20, v20, v22
    v_add_f32 v21, v21, v23
    s_nop 1
    v_permlane32_swap_b32 v20, v21
    v_add_f32 v20, v20, v21
    v_mov_b32 v21, v20
    s_nop 1
    v_permlane16_swap_b32 v20, v21
    v_add_f32 v20, v20, v21
    s_nop 1
    v_add_f32_dpp v20, v20, v20 row_ror:8 row_mask:0xf bank_mask:0xf
    v_cvt_pk_bf16_f32 v22, v20, v20
    v_lshlrev_b32 v22, 16, v22
    v_add_f32 v20, v22, v71
    v_cvt_pk_bf16_f32 v20, v20, v20
    v_lshlrev_b32 v20, 16, v20
    v_mul_f32 v21, 0xbfb8aa3b, v20
    v_exp_f32 v21, v21
    s_nop 0
    v_add_f32 v21, 1.0, v21
    v_rcp_f32 v21, v21
    s_nop 0
    v_mul_f32 v20, v20, v21
    v_cvt_pk_bf16_f32 v20, v20, v20
    v_lshlrev_b32 v20, 16, v20
    s_mov_b64 exec, -1
    s_nop 0
    v_permlane32_swap_b32 v20, v21
    v_mul_f32 v22, v22, v21
    v_cvt_pk_bf16_f32 v22, v22, v22
    v_lshlrev_b32 v22, 16, v22
    v_add_f32 v22, v22, v70
    v_cvt_pk_bf16_f32 v22, v22, v22
    s_mov_b64 exec, 0xff
    buffer_store_short v22, v72, s[28:31], 0 offen
    s_cmp_lg_u32 s2, 0
    s_cbranch_scc1 L_qend
    s_mov_b64 exec, 1
    v_mov_b32 v1, 0
    v_mov_b32 v2, s66
    buffer_store_dword v2, v1, s[32:35], 0 offen
L_qend:
    s_endpgm
L_kv2:
    s_load_dword s66, s[32:33], 0
    v_lshlrev_b32 v1, 4, v0
    s_mov_b32 s19, 0x20000
    s_mov_b32 s23, 0x20000
    s_mov_b32 s34, 2097152
    s_mov_b32 s35, 0x20000
    s_mov_b32 s18, 4194304
    s_mov_b32 s22, 1409024
    s_mov_b64 s[16:17], s[44:45]
    s_mov_b64 s[20:21], s[52:53]
    v_lshlrev_b32 v2, 1, v6
    v_xor_b32 v2, v2, v0
    v_and_b32 v2, 7, v2
    v_lshlrev_b32 v2, 4, v2
    v_lshrrev_b32 v3, 3, v0
    v_lshl_add_u32 v2, v3, 10, v2
    s_lshl_b32 s62, s4, 17
    s_lshl_b32 s63, s5, 7
    s_add_u32 s62, s62, s63
    s_lshl_b32 s64, s7, 15
    s_add_u32 s62, s62, s64
    s_lshl_b32 s64, s6, 13
    s_add_u32 s63, s63, s64
    s_lshl_b32 s64, s7, 13
    s_add_u32 s63, s63, s64
    s_add_u32 s64, s63, 0x8000
    s_cmp_lt_u32 s7, 2
    s_cselect_b32 s64, s64, 0x40000000
    v_and_b32 v20, 1, v0
    v_bfe_u32 v21, v0, 1, 2
    v_cmp_eq_u32 vcc, 1, v20
    v_mov_b32 v22, 0x0c0c0100
    v_mov_b32 v23, 0x01000c0c
    v_cndmask_b32 v22, v22, v23, vcc
    v_mov_b32 v23, 0x0c0c0302
    v_mov_b32 v24, 0x03020c0c
    v_cndmask_b32 v23, v23, v24, vcc
    v_mov_b32 v24, 0x0c0c0c0c
    v_cmp_eq_u32 vcc, 0, v21
    s_nop 1
    v_cndmask_b32 v12, v24, v22, vcc
    v_cndmask_b32 v16, v24, v23, vcc
    v_cmp_eq_u32 vcc, 1, v21
    s_nop 1
    v_cndmask_b32 v13, v24, v22, vcc
    v_cndmask_b32 v17, v24, v23, vcc
    v_cmp_eq_u32 vcc, 2, v21
    s_nop 1
    v_cndmask_b32 v14, v24, v22, vcc
    v_cndmask_b32 v18, v24, v23, vcc
    v_cmp_eq_u32 vcc, 3, v21
    s_nop 1
    v_cndmask_b32 v15, v24, v22, vcc
    v_cndmask_b32 v19, v24, v23, vcc
    s_waitcnt vmcnt(5)
    buffer_load_dwordx4 v[100:103], v69, s[8:11], s84 offen nt
    s_add_u32 s84, s84, 4096
    s_and_b32 s84, s84, 0xffff
    s_waitcnt vmcnt(5)
    buffer_load_dwordx4 v[104:107], v69, s[8:11], s84 offen nt
    s_add_u32 s84, s84, 4096
    s_and_b32 s84, s84, 0xffff
    s_waitcnt vmcnt(5)
    buffer_load_dwordx4 v[108:111], v69, s[8:11], s84 offen nt
    s_add_u32 s84, s84, 4096
    s_and_b32 s84, s84, 0xffff
    s_waitcnt vmcnt(5)
    buffer_load_dwordx4 v[112:115], v69, s[8:11], s84 offen nt
    s_add_u32 s84, s84, 4096
    s_and_b32 s84, s84, 0xffff
    s_waitcnt vmcnt(5)
    buffer_load_dwordx4 v[116:119], v69, s[8:11], s84 offen nt
    s_add_u32 s84, s84, 4096
    s_and_b32 s84, s84, 0xffff
    s_waitcnt vmcnt(5)
    buffer_load_dwordx4 v[120:123], v69, s[8:11], s84 offen nt
    s_add_u32 s84, s84, 4096
    s_and_b32 s84, s84, 0xffff
    s_waitcnt vmcnt(7)
    buffer_load_dwordx4 v[124:127], v69, s[8:11], s84 offen nt
    s_add_u32 s84, s84, 4096
    s_and_b32 s84, s84, 0xffff
    s_waitcnt vmcnt(7)
    buffer_load_dwordx4 v[128:131], v69, s[8:11], s84 offen nt
    s_add_u32 s84, s84, 4096
    s_and_b32 s84, s84, 0xffff
    s_waitcnt vmcnt(7)
    buffer_load_dwordx4 v[132:135], v69, s[8:11], s84 offen nt
    s_add_u32 s84, s84, 4096
    s_and_b32 s84, s84, 0xffff
    s_waitcnt vmcnt(7)
    buffer_load_dwordx4 v[136:139], v69, s[8:11], s84 offen nt
    s_add_u32 s84, s84, 4096
    s_and_b32 s84, s84, 0xffff
    s_waitcnt vmcnt(7)
    buffer_load_dwordx4 v[140:143], v69, s[12:15], s84 offen nt
    s_add_u32 s84, s84, 4096
    s_and_b32 s84, s84, 0xffff
    s_waitcnt vmcnt(7)
    buffer_load_dwordx4 v[144:147], v69, s[12:15], s84 offen nt
    s_add_u32 s84, s84, 4096
    s_and_b32 s84, s84, 0xffff
    s_waitcnt vmcnt(7)
    buffer_load_dwordx4 v[148:151], v69, s[12:15], s84 offen nt
    s_add_u32 s84, s84, 4096
    s_and_b32 s84, s84, 0xffff
    s_waitcnt vmcnt(7)
    buffer_load_dwordx4 v[152:155], v69, s[12:15], s84 offen nt
    s_add_u32 s84, s84, 4096
    s_and_b32 s84, s84, 0xffff
    s_waitcnt vmcnt(7)
    buffer_load_dwordx4 v[156:159], v69, s[12:15], s84 offen nt
    s_add_u32 s84, s84, 4096
    s_and_b32 s84, s84, 0xffff
    s_waitcnt vmcnt(7)
    buffer_load_dwordx4 v[160:163], v69, s[12:15], s84 offen nt
    s_add_u32 s84, s84, 4096
    s_and_b32 s84, s84, 0xffff
    s_waitcnt vmcnt(7)
    buffer_load_dwordx4 v[164:167], v69, s[12:15], s84 offen nt
    s_add_u32 s84, s84, 4096
    s_and_b32 s84, s84, 0xffff
    s_waitcnt vmcnt(7)
    buffer_load_dwordx4 v[168:171], v69, s[12:15], s84 offen nt
    s_add_u32 s84, s84, 4096
    s_and_b32 s84, s84, 0xffff
    s_waitcnt vmcnt(7)
    buffer_load_dwordx4 v[172:175], v69, s[12:15], s84 offen nt
    s_add_u32 s84, s84, 4096
    s_and_b32 s84, s84, 0xffff
    v_lshlrev_b32 v3, 4, v7
    s_waitcnt lgkmcnt(0)
    s_add_u32 s66, s66, 0x9e3779b9
    v_mov_b32 v21, 0
    s_mov_b32 s85, 0
    s_mov_b32 s68, 1048576
    ds_read_b32 v20, v21 offset:24992
    ds_read_b128 v[8:11], v3 offset:24576
    s_waitcnt lgkmcnt(0)
    v_readfirstlane_b32 s67, v20
    s_cmp_lg_u32 s67, 0
    s_cbranch_scc1 L_haveq
    s_waitcnt vmcnt(7)
    buffer_load_dwordx4 v[176:179], v69, s[12:15], s84 offen nt
    s_add_u32 s84, s84, 4096
    s_and_b32 s84, s84, 0xffff
    s_mov_b32 s85, 26
    ds_read_b32 v20, v21 offset:24992
    ds_read_b128 v[8:11], v3 offset:24576
    s_waitcnt lgkmcnt(0)
    v_readfirstlane_b32 s67, v20
    s_cmp_lg_u32 s67, 0
    s_cbranch_scc1 L_haveq
    s_waitcnt vmcnt(7)
    buffer_load_dwordx4 v[180:183], v69, s[12:15], s84 offen nt
    s_add_u32 s84, s84, 4096
    s_and_b32 s84, s84, 0xffff
    s_mov_b32 s85, 27
    ds_read_b32 v20, v21 offset:24992
    ds_read_b128 v[8:11], v3 offset:24576
    s_waitcnt lgkmcnt(0)
    v_readfirstlane_b32 s67, v20
    s_cmp_lg_u32 s67, 0
    s_cbranch_scc1 L_haveq
    s_waitcnt vmcnt(7)
    buffer_load_dwordx4 v[184:187], v69, s[12:15], s84 offen nt
    s_add_u32 s84, s84, 4096
    s_and_b32 s84, s84, 0xffff
    s_mov_b32 s85, 28
    ds_read_b32 v20, v21 offset:24992
    ds_read_b128 v[8:11], v3 offset:24576
    s_waitcnt lgkmcnt(0)
    v_readfirstlane_b32 s67, v20
    s_cmp_lg_u32 s67, 0
    s_cbranch_scc1 L_haveq
    s_waitcnt vmcnt(7)
    buffer_load_dwordx4 v[188:191], v69, s[12:15], s84 offen nt
    s_add_u32 s84, s84, 4096
    s_and_b32 s84, s84, 0xffff
    s_mov_b32 s85, 29
    ds_read_b32 v20, v21 offset:24992
    ds_read_b128 v[8:11], v3 offset:24576
    s_waitcnt lgkmcnt(0)
    v_readfirstlane_b32 s67, v20
    s_cmp_lg_u32 s67, 0
    s_cbranch_scc1 L_haveq
    s_waitcnt vmcnt(7)
    buffer_load_dwordx4 v[192:195], v69, s[12:15], s84 offen nt
    s_add_u32 s84, s84, 4096
    s_and_b32 s84, s84, 0xffff
    s_mov_b32 s85, 30
    ds_read_b32 v20, v21 offset:24992
    ds_read_b128 v[8:11], v3 offset:24576
    s_waitcnt lgkmcnt(0)
    v_readfirstlane_b32 s67, v20
    s_cmp_lg_u32 s67, 0
    s_cbranch_scc1 L_haveq
    s_waitcnt vmcnt(7)
    buffer_load_dwordx4 v[196:199], v69, s[12:15], s84 offen nt
    s_add_u32 s84, s84, 4096
    s_and_b32 s84, s84, 0xffff
    s_mov_b32 s85, 31
    ds_read_b32 v20, v21 offset:24992
    ds_read_b128 v[8:11], v3 offset:24576
    s_waitcnt lgkmcnt(0)
    v_readfirstlane_b32 s67, v20
    s_cmp_lg_u32 s67, 0
    s_cbranch_scc1 L_haveq
    s_waitcnt vmcnt(7)
    buffer_load_dwordx4 v[200:203], v69, s[12:15], s84 offen nt
    s_mov_b32 s85, 32
L_noq:
    ds_read_b32 v20, v21 offset:24992
    ds_read_b128 v[8:11], v3 offset:24576
    s_waitcnt lgkmcnt(0)
    v_readfirstlane_b32 s67, v20
    s_cmp_lg_u32 s67, 0
    s_cbranch_scc1 L_haveq
    s_sub_u32 s68, s68, 1
    s_cbranch_scc0 L_noq
L_haveq:
    s_cmp_gt_u32 s85, 25
    s_cbranch_scc1 L_sk25
    s_waitcnt vmcnt(7)
    buffer_load_dwordx4 v[176:179], v69, s[12:15], s84 offen nt
    s_add_u32 s84, s84, 4096
    s_and_b32 s84, s84, 0xffff
L_sk25:
    s_waitcnt vmcnt(10)
    v_dot2_f32_bf16 v20, v76, v8, 0
    v_dot2_f32_bf16 v21, v80, v8, 0
    v_dot2_f32_bf16 v22, v84, v8, 0
    v_dot2_f32_bf16 v23, v88, v8, 0
    v_dot2_f32_bf16 v24, v92, v8, 0
    v_dot2_f32_bf16 v25, v96, v8, 0
    v_dot2_f32_bf16 v26, v100, v8, 0
    v_dot2_f32_bf16 v27, v104, v8, 0
    v_dot2_f32_bf16 v28, v108, v8, 0
    v_dot2_f32_bf16 v29, v112, v8, 0
    v_dot2_f32_bf16 v30, v116, v8, 0
    v_dot2_f32_bf16 v31, v120, v8, 0
    v_dot2_f32_bf16 v32, v124, v8, 0
    v_dot2_f32_bf16 v33, v128, v8, 0
    v_dot2_f32_bf16 v34, v132, v8, 0
    v_dot2_f32_bf16 v35, v136, v8, 0
    s_cmp_gt_u32 s85, 26
    s_cbranch_scc1 L_sk26
    s_waitcnt vmcnt(7)
    buffer_load_dwordx4 v[180:183], v69, s[12:15], s84 offen nt
    s_add_u32 s84, s84, 4096
    s_and_b32 s84, s84, 0xffff
L_sk26:
    v_dot2c_f32_bf16 v20, v77, v9
    v_dot2c_f32_bf16 v21, v81, v9
    v_dot2c_f32_bf16 v22, v85, v9
    v_dot2c_f32_bf16 v23, v89, v9
    v_dot2c_f32_bf16 v24, v93, v9
    v_dot2c_f32_bf16 v25, v97, v9
    v_dot2c_f32_bf16 v26, v101, v9
    v_dot2c_f32_bf16 v27, v105, v9
    v_dot2c_f32_bf16 v28, v109, v9
    v_dot2c_f32_bf16 v29, v113, v9
    v_dot2c_f32_bf16 v30, v117, v9
    v_dot2c_f32_bf16 v31, v121, v9
    v_dot2c_f32_bf16 v32, v125, v9
    v_dot2c_f32_bf16 v33, v129, v9
    v_dot2c_f32_bf16 v34, v133, v9
    v_dot2c_f32_bf16 v35, v137, v9
    s_cmp_gt_u32 s85, 27
    s_cbranch_scc1 L_sk27
    s_waitcnt vmcnt(7)
    buffer_load_dwordx4 v[184:187], v69, s[12:15], s84 offen nt
    s_add_u32 s84, s84, 4096
    s_and_b32 s84, s84, 0xffff
L_sk27:
    v_dot2c_f32_bf16 v20, v78, v10
    v_dot2c_f32_bf16 v21, v82, v10
    v_dot2c_f32_bf16 v22, v86, v10
    v_dot2c_f32_bf16 v23, v90, v10
    v_dot2c_f32_bf16 v24, v94, v10
    v_dot2c_f32_bf16 v25, v98, v10
    v_dot2c_f32_bf16 v26, v102, v10
    v_dot2c_f32_bf16 v27, v106, v10
    v_dot2c_f32_bf16 v28, v110, v10
    v_dot2c_f32_bf16 v29, v114, v10
    v_dot2c_f32_bf16 v30, v118, v10
    v_dot2c_f32_bf16 v31, v122, v10
    v_dot2c_f32_bf16 v32, v126, v10
    v_dot2c_f32_bf16 v33, v130, v10
    v_dot2c_f32_bf16 v34, v134, v10
    v_dot2c_f32_bf16 v35, v138, v10
    s_cmp_gt_u32 s85, 28
    s_cbranch_scc1 L_sk28
    s_waitcnt vmcnt(7)
    buffer_load_dwordx4 v[188:191], v69, s[12:15], s84 offen nt
    s_add_u32 s84, s84, 4096
    s_and_b32 s84, s84, 0xffff
L_sk28:
    v_dot2c_f32_bf16 v20, v79, v11
    v_dot2c_f32_bf16 v21, v83, v11
    v_dot2c_f32_bf16 v22, v87, v11
    v_dot2c_f32_bf16 v23, v91, v11
    v_dot2c_f32_bf16 v24, v95, v11
    v_dot2c_f32_bf16 v25, v99, v11
    v_dot2c_f32_bf16 v26, v103, v11
    v_dot2c_f32_bf16 v27, v107, v11
    v_dot2c_f32_bf16 v28, v111, v11
    v_dot2c_f32_bf16 v29, v115, v11
    v_dot2c_f32_bf16 v30, v119, v11
    v_dot2c_f32_bf16 v31, v123, v11
    v_dot2c_f32_bf16 v32, v127, v11
    v_dot2c_f32_bf16 v33, v131, v11
    v_dot2c_f32_bf16 v34, v135, v11
    v_dot2c_f32_bf16 v35, v139, v11
    s_cmp_gt_u32 s85, 29
    s_cbranch_scc1 L_sk29
    s_waitcnt vmcnt(7)
    buffer_load_dwordx4 v[192:195], v69, s[12:15], s84 offen nt
    s_add_u32 s84, s84, 4096
    s_and_b32 s84, s84, 0xffff
L_sk29:
    s_nop 1
    v_add_f32_dpp v20, v20, v20 row_ror:8 row_mask:0xf bank_mask:0x3
    v_add_f32_dpp v21, v21, v21 row_ror:8 row_mask:0xf bank_mask:0x3
    v_add_f32_dpp v22, v22, v22 row_ror:8 row_mask:0xf bank_mask:0x3
    v_add_f32_dpp v23, v23, v23 row_ror:8 row_mask:0xf bank_mask:0x3
    v_add_f32_dpp v24, v24, v24 row_ror:8 row_mask:0xf bank_mask:0x3
    v_add_f32_dpp v25, v25, v25 row_ror:8 row_mask:0xf bank_mask:0x3
    v_add_f32_dpp v26, v26, v26 row_ror:8 row_mask:0xf bank_mask:0x3
    v_add_f32_dpp v27, v27, v27 row_ror:8 row_mask:0xf bank_mask:0x3
    v_add_f32_dpp v20, v28, v28 row_ror:8 row_mask:0xf bank_mask:0xc
    v_add_f32_dpp v21, v29, v29 row_ror:8 row_mask:0xf bank_mask:0xc
    v_add_f32_dpp v22, v30, v30 row_ror:8 row_mask:0xf bank_mask:0xc
    v_add_f32_dpp v23, v31, v31 row_ror:8 row_mask:0xf bank_mask:0xc
    v_add_f32_dpp v24, v32, v32 row_ror:8 row_mask:0xf bank_mask:0xc
    v_add_f32_dpp v25, v33, v33 row_ror:8 row_mask:0xf bank_mask:0xc
    v_add_f32_dpp v26, v34, v34 row_ror:8 row_mask:0xf bank_mask:0xc
    v_add_f32_dpp v27, v35, v35 row_ror:8 row_mask:0xf bank_mask:0xc
    v_add_f32_dpp v20, v20, v20 row_half_mirror row_mask:0xf bank_mask:0x5
    v_add_f32_dpp v21, v21, v21 row_half_mirror row_mask:0xf bank_mask:0x5
    v_add_f32_dpp v22, v22, v22 row_half_mirror row_mask:0xf bank_mask:0x5
    v_add_f32_dpp v23, v23, v23 row_half_mirror row_mask:0xf bank_mask:0x5
    v_add_f32_dpp v20, v24, v24 row_half_mirror row_mask:0xf bank_mask:0xa
    v_add_f32_dpp v21, v25, v25 row_half_mirror row_mask:0xf bank_mask:0xa
    v_add_f32_dpp v22, v26, v26 row_half_mirror row_mask:0xf bank_mask:0xa
    v_add_f32_dpp v23, v27, v27 row_half_mirror row_mask:0xf bank_mask:0xa
    v_add_f32_dpp v20, v20, v20 quad_perm:[1,0,3,2] row_mask:0xf bank_mask:0xf
    v_add_f32_dpp v21, v21, v21 quad_perm:[1,0,3,2] row_mask:0xf bank_mask:0xf
    v_add_f32_dpp v22, v22, v22 quad_perm:[1,0,3,2] row_mask:0xf bank_mask:0xf
    v_add_f32_dpp v23, v23, v23 quad_perm:[1,0,3,2] row_mask:0xf bank_mask:0xf
    v_add_f32_dpp v20, v20, v20 quad_perm:[2,3,0,1] row_mask:0xf bank_mask:0xf
    v_add_f32_dpp v21, v21, v21 quad_perm:[2,3,0,1] row_mask:0xf bank_mask:0xf
    v_add_f32_dpp v22, v22, v22 quad_perm:[2,3,0,1] row_mask:0xf bank_mask:0xf
    v_add_f32_dpp v23, v23, v23 quad_perm:[2,3,0,1] row_mask:0xf bank_mask:0xf
    s_cmp_gt_u32 s85, 30
    s_cbranch_scc1 L_sk30
    s_waitcnt vmcnt(7)
    buffer_load_dwordx4 v[196:199], v69, s[12:15], s84 offen nt
    s_add_u32 s84, s84, 4096
    s_and_b32 s84, s84, 0xffff
L_sk30:
    v_cvt_pk_bf16_f32 v24, v20, v21
    v_cvt_pk_bf16_f32 v25, v22, v23
    s_mov_b32 s67, 0x3db504f3
    v_lshlrev_b32 v20, 16, v24
    v_and_b32 v21, 0xffff0000, v24
    v_lshlrev_b32 v22, 16, v25
    v_and_b32 v23, 0xffff0000, v25
    v_mul_f32 v20, s67, v20
    v_mul_f32 v21, s67, v21
    v_mul_f32 v22, s67, v22
    v_mul_f32 v23, s67, v23
    v_cvt_pk_bf16_f32 v24, v20, v21
    v_cvt_pk_bf16_f32 v25, v22, v23
    s_mov_b32 s67, 0x3fb8aa3b
    v_lshlrev_b32 v20, 16, v24
    v_and_b32 v21, 0xffff0000, v24
    v_lshlrev_b32 v22, 16, v25
    v_and_b32 v23, 0xffff0000, v25
    v_max3_f32 v24, v20, v21, v22
    v_max_f32 v24, v24, v23
    s_nop 1
    v_max_f32_dpp v24, v24, v24 row_half_mirror row_mask:0xf bank_mask:0xf
    s_nop 1
    v_max_f32_dpp v24, v24, v24 row_mirror row_mask:0xf bank_mask:0xf
    v_mov_b32 v25, v24
    s_nop 1
    v_permlane16_swap_b32 v24, v25
    v_max_f32 v24, v24, v25
    v_mov_b32 v25, v24
    s_nop 1
    v_permlane32_swap_b32 v24, v25
    v_max_f32 v24, v24, v25
    v_mul_f32 v24, s67, v24
    v_fma_f32 v20, v20, s67, -v24
    v_fma_f32 v21, v21, s67, -v24
    v_fma_f32 v22, v22, s67, -v24
    v_fma_f32 v23, v23, s67, -v24
    v_exp_f32 v20, v20
    v_exp_f32 v21, v21
    v_exp_f32 v22, v22
    v_exp_f32 v23, v23
    s_cmp_gt_u32 s85, 31
    s_cbranch_scc1 L_sk31
    s_waitcnt vmcnt(7)
    buffer_load_dwordx4 v[200:203], v69, s[12:15], s84 offen nt
L_sk31:
    s_nop 0
    v_cvt_pk_bf16_f32 v26, v20, v21
    v_cvt_pk_bf16_f32 v27, v22, v23
    v_add_f32 v25, v20, v21
    v_add_f32 v28, v22, v23
    v_add_f32 v25, v25, v28
    v_mov_b32_dpp v44, v26 row_newbcast:0 row_mask:0xf bank_mask:0xf
    v_mov_b32_dpp v45, v27 row_newbcast:0 row_mask:0xf bank_mask:0xf
    v_add_f32_dpp v25, v25, v25 row_half_mirror row_mask:0xf bank_mask:0xf
    v_mov_b32_dpp v46, v26 row_newbcast:4 row_mask:0xf bank_mask:0xf
    v_mov_b32_dpp v47, v27 row_newbcast:4 row_mask:0xf bank_mask:0xf
    v_add_f32_dpp v25, v25, v25 row_mirror row_mask:0xf bank_mask:0xf
    v_mov_b32_dpp v48, v26 row_newbcast:8 row_mask:0xf bank_mask:0xf
    v_mov_b32_dpp v49, v27 row_newbcast:8 row_mask:0xf bank_mask:0xf
    v_mov_b32 v28, v25
    v_mov_b32_dpp v50, v26 row_newbcast:12 row_mask:0xf bank_mask:0xf
    v_mov_b32_dpp v51, v27 row_newbcast:12 row_mask:0xf bank_mask:0xf
    v_permlane16_swap_b32 v25, v28
    v_add_f32 v25, v25, v28
    v_mov_b32 v28, v25
    s_lshl_b32 s67, s7, 3
    v_mov_b32 v3, s67
    v_permlane32_swap_b32 v25, v28
    v_add_f32 v25, v25, v28
    s_mov_b64 exec, 1
    ds_write_b64 v3, v[24:25] offset:24960
    s_mov_b64 exec, -1
    v_perm_b32 v52, v44, v44, v12
    v_perm_b32 v53, v44, v44, v13
    v_perm_b32 v54, v44, v44, v14
    v_perm_b32 v55, v44, v44, v15
    v_perm_b32 v56, v44, v44, v16
    v_perm_b32 v57, v44, v44, v17
    v_perm_b32 v58, v44, v44, v18
    v_perm_b32 v59, v44, v44, v19
    s_waitcnt vmcnt(7)
    s_lshl_b32 s67, s7, 12
    s_add_u32 m0, s67, 0
    s_add_u32 s67, s62, 0
    buffer_load_dwordx4 v2, s[16:19], s67 offen nt lds
    s_waitcnt vmcnt(16)
    v_mfma_f32_16x16x32_bf16 v[60:63], v[52:55], v[140:143], 0
    v_perm_b32 v52, v45, v45, v12
    v_perm_b32 v53, v45, v45, v13
    v_perm_b32 v54, v45, v45, v14
    v_perm_b32 v55, v45, v45, v15
    s_waitcnt vmcnt(15)
    v_mfma_f32_16x16x32_bf16 v[60:63], v[56:59], v[144:147], v[60:63]
    v_perm_b32 v56, v45, v45, v16
    v_perm_b32 v57, v45, v45, v17
    v_perm_b32 v58, v45, v45, v18
    v_perm_b32 v59, v45, v45, v19
    s_waitcnt vmcnt(14)
    v_mfma_f32_16x16x32_bf16 v[60:63], v[52:55], v[148:151], v[60:63]
    v_perm_b32 v52, v46, v46, v12
    v_perm_b32 v53, v46, v46, v13
    v_perm_b32 v54, v46, v46, v14
    v_perm_b32 v55, v46, v46, v15
    s_waitcnt vmcnt(7)
    s_lshl_b32 s67, s7, 12
    s_add_u32 m0, s67, 1024
    s_add_u32 s67, s62, 8192
    buffer_load_dwordx4 v2, s[16:19], s67 offen nt lds
    s_waitcnt vmcnt(14)
    v_mfma_f32_16x16x32_bf16 v[60:63], v[56:59], v[152:155], v[60:63]
    v_perm_b32 v56, v46, v46, v16
    v_perm_b32 v57, v46, v46, v17
    v_perm_b32 v58, v46, v46, v18
    v_perm_b32 v59, v46, v46, v19
    s_waitcnt vmcnt(13)
    v_mfma_f32_16x16x32_bf16 v[60:63], v[52:55], v[156:159], v[60:63]
    v_perm_b32 v52, v47, v47, v12
    v_perm_b32 v53, v47, v47, v13
    v_perm_b32 v54, v47, v47, v14
    v_perm_b32 v55, v47, v47, v15
    s_waitcnt vmcnt(12)
    v_mfma_f32_16x16x32_bf16 v[60:63], v[56:59], v[160:163], v[60:63]
    v_perm_b32 v56, v47, v47, v16
    v_perm_b32 v57, v47, v47, v17
    v_perm_b32 v58, v47, v47, v18
    v_perm_b32 v59, v47, v47, v19
    s_waitcnt vmcnt(11)
    v_mfma_f32_16x16x32_bf16 v[60:63], v[52:55], v[164:167], v[60:63]
    v_perm_b32 v52, v48, v48, v12
    v_perm_b32 v53, v48, v48, v13
    v_perm_b32 v54, v48, v48, v14
    v_perm_b32 v55, v48, v48, v15
    s_waitcnt vmcnt(10)
    v_mfma_f32_16x16x32_bf16 v[60:63], v[56:59], v[168:171], v[60:63]
    v_perm_b32 v56, v48, v48, v16
    v_perm_b32 v57, v48, v48, v17
    v_perm_b32 v58, v48, v48, v18
    v_perm_b32 v59, v48, v48, v19
    s_waitcnt vmcnt(9)
    v_mfma_f32_16x16x32_bf16 v[60:63], v[52:55], v[172:175], v[60:63]
    v_perm_b32 v52, v49, v49, v12
    v_perm_b32 v53, v49, v49, v13
    v_perm_b32 v54, v49, v49, v14
    v_perm_b32 v55, v49, v49, v15
    s_waitcnt vmcnt(8)
    v_mfma_f32_16x16x32_bf16 v[60:63], v[56:59], v[176:179], v[60:63]
    v_perm_b32 v56, v49, v49, v16
    v_perm_b32 v57, v49, v49, v17
    v_perm_b32 v58, v49, v49, v18
    v_perm_b32 v59, v49, v49, v19
    s_waitcnt vmcnt(7)
    v_mfma_f32_16x16x32_bf16 v[60:63], v[52:55], v[180:183], v[60:63]
    s_lshl_b32 s67, s7, 12
    s_add_u32 m0, s67, 2048
    s_add_u32 s67, s62, 16384
    buffer_load_dwordx4 v2, s[16:19], s67 offen nt lds
    v_perm_b32 v52, v50, v50, v12
    v_perm_b32 v53, v50, v50, v13
    v_perm_b32 v54, v50, v50, v14
    v_perm_b32 v55, v50, v50, v15
    s_waitcnt vmcnt(7)
    v_mfma_f32_16x16x32_bf16 v[60:63], v[56:59], v[184:187], v[60:63]
    s_lshl_b32 s67, s7, 12
    s_add_u32 m0, s67, 3072
    s_add_u32 s67, s62, 24576
    buffer_load_dwordx4 v2, s[16:19], s67 offen nt lds
    v_perm_b32 v56, v50, v50, v16
    v_perm_b32 v57, v50, v50, v17
    v_perm_b32 v58, v50, v50, v18
    v_perm_b32 v59, v50, v50, v19
    s_waitcnt vmcnt(7)
    v_mfma_f32_16x16x32_bf16 v[60:63], v[52:55], v[188:191], v[60:63]
    s_lshl_b32 s67, s7, 10
    s_add_u32 m0, s67, 16384
    s_nop 0
    buffer_load_dwordx4 v2, s[20:23], s63 offen nt lds
    v_perm_b32 v52, v51, v51, v12
    v_perm_b32 v53, v51, v51, v13
    v_perm_b32 v54, v51, v51, v14
    v_perm_b32 v55, v51, v51, v15
    s_waitcnt vmcnt(7)
    v_mfma_f32_16x16x32_bf16 v[60:63], v[56:59], v[192:195], v[60:63]
    s_lshl_b32 s67, s7, 10
    s_add_u32 m0, s67, 20480
    s_nop 0
    buffer_load_dwordx4 v2, s[20:23], s64 offen nt lds
    v_perm_b32 v56, v51, v51, v16
    v_perm_b32 v57, v51, v51, v17
    v_perm_b32 v58, v51, v51, v18
    v_perm_b32 v59, v51, v51, v19
    s_waitcnt vmcnt(7)
    v_mfma_f32_16x16x32_bf16 v[60:63], v[52:55], v[196:199], v[60:63]
    v_and_b32 v3, 31, v0
    v_lshlrev_b32 v3, 4, v3
    s_lshl_b32 s67, s7, 9
    v_add_u32 v3, s67, v3
    s_waitcnt vmcnt(6)
    v_mfma_f32_16x16x32_bf16 v[60:63], v[56:59], v[200:203], v[60:63]
    s_mov_b32 exec_hi, 0
    s_nop 6
    ds_write_b128 v3, v[60:63] offset:25024
    s_mov_b64 exec, -1
    s_waitcnt lgkmcnt(0)
    s_barrier
    s_lshl_b32 s60, s4, 12
    s_add_u32 s60, s60, 266240
    v_lshrrev_b32 v3, 2, v7
    v_lshl_add_u32 v3, v6, 2, v3
    v_and_b32 v4, 6, v3
    v_bfe_u32 v5, v7, 1, 1
    s_lshl_b32 s67, s7, 1
    v_add_u32 v5, s67, v5
    v_xor_b32 v4, v4, v5
    v_lshlrev_b32 v4, 4, v4
    v_lshl_add_u32 v4, v3, 7, v4
    v_and_b32 v5, 1, v7
    v_lshl_add_u32 v4, v5, 3, v4
    v_lshlrev_b32 v5, 3, v6
    v_lshrrev_b32 v3, 2, v7
    v_lshl_add_u32 v70, v6, 2, v3
    v_lshlrev_b32 v70, 4, v70
    s_lshl_b32 s61, s5, 15
    s_lshl_b32 s67, s7, 13
    s_add_u32 s61, s61, s67
    s_lshl_b32 s67, s4, 8
    s_add_u32 s61, s61, s67
    s_add_u32 s61, s61, 397312
    v_mov_b32 v42, s66
    v_mov_b32 v43, s66
    s_mov_b32 s68, 1048576
    s_mov_b32 s62, 0xff00ff00
    s_mov_b32 s63, 0xff00ff00
    s_mov_b32 s64, 0x11111111
    s_mov_b32 s65, 0x11111111
    s_mov_b32 s94, 0xf0f0f0f0
    s_mov_b32 s95, 0xf0f0f0f0
    s_waitcnt vmcnt(0)
    s_barrier
    buffer_load_dwordx4 v[76:79], v1, s[32:35], s60 offen offset:0 sc1
    buffer_load_dwordx4 v[80:83], v1, s[32:35], s60 offen offset:1024 sc1
    buffer_load_dwordx4 v[84:87], v1, s[32:35], s60 offen offset:2048 sc1
    buffer_load_dwordx4 v[88:91], v1, s[32:35], s60 offen offset:3072 sc1
    ds_read_b64_tr_b16 v[92:93], v4 offset:0
    ds_read_b64_tr_b16 v[94:95], v4 offset:2048
    ds_read_b64_tr_b16 v[96:97], v4 offset:4096
    ds_read_b64_tr_b16 v[98:99], v4 offset:6144
    ds_read_b64_tr_b16 v[100:101], v4 offset:8192
    ds_read_b64_tr_b16 v[102:103], v4 offset:10240
    ds_read_b64_tr_b16 v[104:105], v4 offset:12288
    ds_read_b64_tr_b16 v[106:107], v4 offset:14336
    ds_read_b64_tr_b16 v[108:109], v4 offset:16384
    ds_read_b64 v[114:115], v5 offset:24832
    ds_read_b64_tr_b16 v[110:111], v4 offset:18432
    ds_read_b64 v[116:117], v5 offset:24864
    ds_read_b64_tr_b16 v[112:113], v4 offset:20480
    ds_read_b64 v[118:119], v5 offset:24896
    s_waitcnt lgkmcnt(4)
    v_mfma_f32_16x16x16_bf16 v[36:39], v[108:109], v[114:115], 0
    s_waitcnt lgkmcnt(2)
    v_mfma_f32_16x16x16_bf16 v[36:39], v[110:111], v[116:117], v[36:39]
    s_waitcnt lgkmcnt(0)
    v_mfma_f32_16x16x16_bf16 v[36:39], v[112:113], v[118:119], v[36:39]
    s_branch L_g1chk
L_g1:
    buffer_load_dwordx4 v[76:79], v1, s[32:35], s60 offen offset:0 sc1
    buffer_load_dwordx4 v[80:83], v1, s[32:35], s60 offen offset:1024 sc1
    buffer_load_dwordx4 v[84:87], v1, s[32:35], s60 offen offset:2048 sc1
    buffer_load_dwordx4 v[88:91], v1, s[32:35], s60 offen offset:3072 sc1
L_g1chk:
    s_waitcnt vmcnt(0)
    v_xor_b32 v24, s66, v76
    v_bitop3_b32 v24, v24, v82, s66 bitop3:0xf6
    v_bitop3_b32 v24, v24, v84, s66 bitop3:0xf6
    v_bitop3_b32 v24, v24, v90, s66 bitop3:0xf6
    v_cmp_ne_u32 vcc, 0, v24
    s_sub_u32 s68, s68, 1
    s_cbranch_scc1 L_g1a
    s_cbranch_vccnz L_g1
L_g1a:
    v_mfma_f32_16x16x32_bf16 v[44:47], v[92:95], v[78:81], 0
    v_max_f32_dpp v20, v77, v77 quad_perm:[1,0,3,2] row_mask:0xf bank_mask:0xf
    v_cndmask_b32 v36, v36, v37, s[94:95]
    v_mfma_f32_16x16x32_bf16 v[44:47], v[96:99], v[86:89], v[44:47]
    v_max_f32_dpp v20, v20, v20 quad_perm:[2,3,0,1] row_mask:0xf bank_mask:0xf
    v_cndmask_b32 v38, v38, v39, s[94:95]
    v_mfma_f32_16x16x32_bf16 v[48:51], v[100:103], v[78:81], 0
    v_max_f32_dpp v20, v20, v20 row_half_mirror row_mask:0xf bank_mask:0xf
    v_mfma_f32_16x16x32_bf16 v[48:51], v[104:107], v[86:89], v[48:51]
    v_sub_f32 v20, v77, v20
    v_exp_f32 v20, v20
    v_cndmask_b32 v41, v36, v38, s[62:63]
    v_mul_f32 v22, v20, v83
L_g1done:
    v_pk_mul_f32 v[44:45], v[44:45], v[20:21] op_sel_hi:[1,0]
    v_pk_mul_f32 v[46:47], v[46:47], v[20:21] op_sel_hi:[1,0]
    v_add_f32_dpp v22, v22, v22 quad_perm:[1,0,3,2] row_mask:0xf bank_mask:0xf
    s_nop 0
    v_pk_mul_f32 v[48:49], v[48:49], v[20:21] op_sel_hi:[1,0]
    v_add_f32_dpp v22, v22, v22 quad_perm:[2,3,0,1] row_mask:0xf bank_mask:0xf
    v_pk_mul_f32 v[50:51], v[50:51], v[20:21] op_sel_hi:[1,0]
    v_add_f32_dpp v60, v48, v44 row_ror:8 row_mask:0xf bank_mask:0x3
    v_add_f32_dpp v22, v22, v22 row_half_mirror row_mask:0xf bank_mask:0xf
    v_add_f32_dpp v61, v49, v45 row_ror:8 row_mask:0xf bank_mask:0x3
    v_add_f32_dpp v60, v46, v50 row_ror:8 row_mask:0xf bank_mask:0xc
    v_rcp_f32 v22, v22
    v_add_f32_dpp v61, v47, v51 row_ror:8 row_mask:0xf bank_mask:0xc
    v_add_f32_dpp v40, v60, v60 row_half_mirror row_mask:0xf bank_mask:0x5
    s_nop 1
    v_add_f32_dpp v40, v61, v61 row_half_mirror row_mask:0xf bank_mask:0xa
    s_nop 1
    v_add_f32_dpp v40, v40, v40 quad_perm:[1,0,3,2] row_mask:0xf bank_mask:0xf
    s_nop 1
    v_add_f32_dpp v40, v40, v40 quad_perm:[2,3,0,1] row_mask:0xf bank_mask:0xf
    s_mov_b64 exec, s[64:65]
    v_mul_f32 v40, v40, v22
    buffer_store_dwordx4 v[40:43], v70, s[32:35], s61 offen sc1
    s_barrier
L_end:
    s_endpgm
.section .rodata,"a"
.p2align 6
.amdhsa_kernel recurrent_scan__sliding_block_cached__mixer_channel_mlp__decode_kernel
  .amdhsa_next_free_vgpr 204
  .amdhsa_next_free_sgpr 102
  .amdhsa_accum_offset 204
  .amdhsa_group_segment_fixed_size 0
  .amdhsa_kernarg_size 104
  .amdhsa_user_sgpr_count 2
  .amdhsa_user_sgpr_kernarg_segment_ptr 1
  .amdhsa_system_sgpr_workgroup_id_x 1
  .amdhsa_float_denorm_mode_32 3
.end_amdhsa_kernel
```
